```python
import torch

def _softmax(x, axis=-1):
    return torch.softmax(x, dim=axis)
def _gelu(x):
    return torch.nn.functional.gelu(x, approximate="tanh")
def _silu(x):
    return torch.nn.functional.silu(x)
def _sigmoid(x):
    return torch.sigmoid(x)
def _layernorm(x, axis=-1, eps=1e-5):
    m = x.mean(dim=axis, keepdim=True)
    v = x.var(dim=axis, keepdim=True, unbiased=False)
    return (x - m) / torch.sqrt(v + eps)
def _scatter_add(tgt, idx, src, axis=0):
    return tgt.clone().index_add_(axis, idx, src)
def _segment_sum(src, seg, n):
    out = torch.zeros((n,) + src.shape[1:], dtype=src.dtype)
    return out.index_add_(0, seg, src)
def _pad(x, pw):
    flat = tuple(v for pair in reversed(pw) for v in pair)
    return torch.nn.functional.pad(x, flat)

kernel_name = 'standalone__sliding_block_cached__decode'

def setup_inputs():

    _w = (lambda a: (lambda t: t.to(torch.bfloat16) if t.is_floating_point() else t)(torch.as_tensor(a)))
    B, Sq, D = 1, 1, 512
    Hq, Hkv, Sk, Dh = 32, 8, 32768, 128
    assert Hq % Hkv == 0, (Hq, Hkv)
    return {
        "x": _w((lambda *s: torch.randn(*s, dtype=torch.bfloat16) * 0.8)(B, Sq, D)),
        "k_cache": _w((lambda *s: torch.randn(*s, dtype=torch.bfloat16) * 0.8)(B, Hkv, Sk, Dh)),
        "v_cache": _w((lambda *s: torch.randn(*s, dtype=torch.bfloat16) * 0.05)(B, Hkv, Sk, Dh)),
        "wq": _w((lambda *s: torch.randn(*s, dtype=torch.bfloat16) * 0.8)(D, Hq * Dh) * (D ** -0.5)),
        "wo": _w((lambda *s: torch.randn(*s, dtype=torch.bfloat16) * 0.05)(Hq * Dh, D) * ((Hq * Dh) ** -0.5)),
    }

def reference(x, k_cache, v_cache, wq, wo):
    B, Sq, D = x.shape
    Hq, Dh = 32, 128
    Hkv, Sk = k_cache.shape[1], k_cache.shape[2]
    W = min(4096, max(256, Sk // 4))
    rep = Hq // Hkv
    q = (lambda x, *d: x.permute(*d))((x @ wq).reshape(B, Sq, Hq, Dh), 0, 2, 1, 3)
    k = (lambda x, n, axis: torch.repeat_interleave(x, n, dim=axis))(k_cache[:, :, Sk - W:, :], rep, axis=1)
    v = (lambda x, n, axis: torch.repeat_interleave(x, n, dim=axis))(v_cache[:, :, Sk - W:, :], rep, axis=1)
    scores = torch.einsum("bhqd,bhkd->bhqk", q, k) * (Dh ** -0.5)
    p = _softmax(scores, axis=-1)
    o = torch.einsum("bhqk,bhkd->bhqd", p, v)
    return (lambda x, *d: x.permute(*d))(o, 0, 2, 1, 3).reshape(B, Sq, Hq * Dh) @ wo
```

```asm
; @launch grid=(256,1,1) block=(512,1,1) lds=44288
.amdgcn_target "amdgcn-amd-amdhsa--gfx950"
.text
.globl standalone__sliding_block_cached__decode_kernel
.p2align 8
.type standalone__sliding_block_cached__decode_kernel,@function
standalone__sliding_block_cached__decode_kernel:
  s_cmp_ge_u32 s2, 256
  s_cbranch_scc1 L_end2
  s_load_dwordx16 s[40:55], s[0:1], 0
  v_lshrrev_b32 v1, 6, v0
  v_and_b32 v0, 63, v0
  s_and_b32 s92, s2, 7
  s_lshr_b32 s93, s2, 3
  v_readfirstlane_b32 s3, v1
  s_waitcnt lgkmcnt(0)
  s_load_dword s90, s[54:55], 0
  s_mov_b32 s88, s54
  s_mov_b32 s89, s55
  s_mov_b32 s24, s40
  s_and_b32 s25, s41, 0xffff
  s_mov_b32 s26, 1024
  s_mov_b32 s27, 0x00020000
  s_mov_b32 s8, s42
  s_and_b32 s9, s43, 0xffff
  s_mov_b32 s10, 67108864
  s_mov_b32 s11, 0x00020000
  s_mov_b32 s12, s44
  s_and_b32 s13, s45, 0xffff
  s_mov_b32 s14, 67108864
  s_mov_b32 s15, 0x00020000
  s_mov_b32 s28, s46
  s_and_b32 s29, s47, 0xffff
  s_mov_b32 s30, 4194304
  s_mov_b32 s31, 0x00020000
  s_mov_b32 s16, s48
  s_and_b32 s17, s49, 0xffff
  s_mov_b32 s18, 4194304
  s_mov_b32 s19, 0x00020000
  s_mov_b32 s20, s50
  s_and_b32 s21, s51, 0xffff
  s_mov_b32 s22, 1024
  s_mov_b32 s23, 0x00020000
  s_mov_b32 s4, s54
  s_and_b32 s5, s55, 0xffff
  s_mov_b32 s6, 1835008
  s_mov_b32 s7, 0x00020000
  s_and_b32 s91, s3, 3
  s_cmp_ge_u32 s3, 4
  s_cbranch_scc1 L_bwave
L_awave:
  s_setprio 3
  v_lshrrev_b32 v112, 1, v0
  v_and_b32 v113, 1, v0
  s_add_u32 s32, s92, 1
  s_and_b32 s32, s32, 7
  s_lshl_b32 s32, s32, 9
  s_lshl_b32 s33, s93, 4
  s_add_u32 s32, s32, s33
  s_lshl_b32 s33, s91, 7
  v_lshlrev_b32 v114, 2, v112
  v_add_u32 v114, s33, v114
  v_lshlrev_b32 v115, 13, v114
  v_lshl_add_u32 v115, v113, 4, v115
  s_lshl_b32 s34, s32, 1
  v_add_u32 v115, s34, v115
  v_lshlrev_b32 v114, 1, v114
  buffer_load_dwordx4 v[16:19], v115, s[28:31], 0 offen nt
  buffer_load_dwordx2 v[120:121], v114, s[24:27], 0 offen
  s_mov_b32 s33, 8192
  buffer_load_dwordx4 v[20:23], v115, s[28:31], s33 offen nt
  s_mov_b32 s33, 16384
  buffer_load_dwordx4 v[24:27], v115, s[28:31], s33 offen nt
  s_mov_b32 s33, 24576
  buffer_load_dwordx4 v[28:31], v115, s[28:31], s33 offen nt
  v_lshrrev_b32 v116, 4, v0
  v_lshl_add_u32 v116, v113, 3, v116
  v_lshlrev_b32 v116, 2, v116
  s_lshl_b32 s33, s91, 6
  s_add_u32 s33, s33, 34048
  v_add_u32 v116, s33, v116
  v_and_b32 v117, 7, v0
  v_lshlrev_b32 v117, 3, v117
  s_lshl_b32 s33, s32, 2
  s_add_u32 s33, s33, 65536
  v_add_u32 v118, s33, v117
  v_and_b32 v119, 14, v0
  v_cmp_eq_u32 s[96:97], 0, v119
L_a_pre:
  s_lshl_b32 s32, s92, 11
  s_add_u32 s32, s32, 65536
  v_lshlrev_b32 v60, 4, v0
  v_add_u32 v60, s32, v60
  v_lshrrev_b32 v61, 5, v0
  v_mul_u32_u24 v61, 64, v61
  v_lshl_add_u32 v61, v0, 3, v61
  v_add_u32 v61, 32768, v61
  v_lshrrev_b32 v8, 4, v0
  v_and_b32 v14, 7, v0
  v_lshlrev_b32 v14, 3, v14
  s_lshr_b32 s32, s92, 1
  s_add_u32 s32, s32, 1
  s_and_b32 s32, s32, 3
  s_lshl_b32 s32, s32, 3
  s_lshr_b32 s34, s93, 2
  s_add_u32 s34, s34, s32
  s_and_b32 s35, s93, 3
  s_and_b32 s36, s92, 1
  s_xor_b32 s36, s36, 1
  s_lshl_b32 s37, s91, 1
  s_add_u32 s36, s36, s37
  v_and_b32 v3, 7, v0
  v_lshrrev_b32 v2, 3, v0
  s_lshl_b32 s32, s34, 7
  s_lshl_b32 s33, s35, 5
  s_add_u32 s32, s32, s33
  v_lshlrev_b32 v4, 2, v2
  v_add_u32 v4, s32, v4
  v_lshlrev_b32 v5, 10, v4
  v_lshl_add_u32 v5, v3, 4, v5
  s_lshl_b32 s33, s36, 7
  v_add_u32 v5, s33, v5
  s_lshl_b32 s32, s34, 9
  s_add_u32 s32, s32, 196608
  v_and_b32 v9, 31, v0
  v_lshlrev_b32 v9, 4, v9
  v_add_u32 v9, s32, v9
  s_lshl_b32 s33, s91, 6
  s_add_u32 s33, s33, 44032
  v_lshlrev_b32 v12, 3, v2
  v_add_u32 v12, s33, v12
  v_and_b32 v59, 31, v0
  v_lshlrev_b32 v59, 3, v59
  v_add_u32 v59, 44032, v59
  s_lshl_b32 s32, s34, 15
  s_lshl_b32 s33, s91, 13
  s_add_u32 s32, s32, s33
  s_lshl_b32 s33, s35, 8
  s_add_u32 s32, s32, s33
  s_add_u32 s32, s32, 262144
  v_lshlrev_b32 v15, 10, v2
  v_lshl_add_u32 v15, v14, 2, v15
  v_add_u32 v15, s32, v15
  v_lshlrev_b32 v13, 2, v8
  v_lshl_add_u32 v13, v14, 1, v13
  s_lshl_b32 s33, s91, 7
  s_add_u32 s33, s33, 43520
  v_add_u32 v13, s33, v13
  v_and_b32 v4, 8, v0
  v_cmp_eq_u32 s[94:95], 0, v4
  v_lshlrev_b32 v4, 4, v2
  v_lshl_add_u32 v62, v3, 2, v8
  v_lshlrev_b32 v62, 14, v62
  s_lshl_b32 s32, s36, 11
  s_lshr_b32 s33, s92, 1
  s_lshl_b32 s33, s33, 5
  s_add_u32 s33, s33, s93
  s_lshl_b32 s33, s33, 4
  s_add_u32 s32, s32, s33
  s_add_u32 s32, s32, 1310720
  v_add_u32 v62, s32, v62
  s_lshl_b32 s32, s2, 11
  s_add_u32 s32, s32, 1310720
  v_lshlrev_b32 v1, 4, v0
  v_add_u32 v1, s32, v1
  s_waitcnt lgkmcnt(0)
  s_add_u32 s90, s90, 1
  s_waitcnt vmcnt(3)
  v_lshlrev_b32 v48, 16, v120
  v_and_b32 v49, 0xffff0000, v120
  v_lshlrev_b32 v50, 16, v121
  v_and_b32 v51, 0xffff0000, v121
  v_lshlrev_b32 v72, 16, v16
  v_and_b32 v73, 0xffff0000, v16
  v_mul_f32 v64, v48, v72
  v_mul_f32 v65, v48, v73
  v_lshlrev_b32 v74, 16, v17
  v_and_b32 v75, 0xffff0000, v17
  v_mul_f32 v66, v48, v74
  v_mul_f32 v67, v48, v75
  v_lshlrev_b32 v72, 16, v18
  v_and_b32 v73, 0xffff0000, v18
  v_mul_f32 v68, v48, v72
  v_mul_f32 v69, v48, v73
  v_lshlrev_b32 v74, 16, v19
  v_and_b32 v75, 0xffff0000, v19
  v_mul_f32 v70, v48, v74
  v_mul_f32 v71, v48, v75
  s_waitcnt vmcnt(2)
  v_lshlrev_b32 v72, 16, v20
  v_and_b32 v73, 0xffff0000, v20
  v_fmac_f32 v64, v49, v72
  v_fmac_f32 v65, v49, v73
  v_lshlrev_b32 v74, 16, v21
  v_and_b32 v75, 0xffff0000, v21
  v_fmac_f32 v66, v49, v74
  v_fmac_f32 v67, v49, v75
  v_lshlrev_b32 v72, 16, v22
  v_and_b32 v73, 0xffff0000, v22
  v_fmac_f32 v68, v49, v72
  v_fmac_f32 v69, v49, v73
  v_lshlrev_b32 v74, 16, v23
  v_and_b32 v75, 0xffff0000, v23
  v_fmac_f32 v70, v49, v74
  v_fmac_f32 v71, v49, v75
  s_waitcnt vmcnt(1)
  v_lshlrev_b32 v72, 16, v24
  v_and_b32 v73, 0xffff0000, v24
  v_fmac_f32 v64, v50, v72
  v_fmac_f32 v65, v50, v73
  v_lshlrev_b32 v74, 16, v25
  v_and_b32 v75, 0xffff0000, v25
  v_fmac_f32 v66, v50, v74
  v_fmac_f32 v67, v50, v75
  v_lshlrev_b32 v72, 16, v26
  v_and_b32 v73, 0xffff0000, v26
  v_fmac_f32 v68, v50, v72
  v_fmac_f32 v69, v50, v73
  v_lshlrev_b32 v74, 16, v27
  v_and_b32 v75, 0xffff0000, v27
  v_fmac_f32 v70, v50, v74
  v_fmac_f32 v71, v50, v75
  s_waitcnt vmcnt(0)
  v_lshlrev_b32 v72, 16, v28
  v_and_b32 v73, 0xffff0000, v28
  v_fmac_f32 v64, v51, v72
  v_fmac_f32 v65, v51, v73
  v_lshlrev_b32 v74, 16, v29
  v_and_b32 v75, 0xffff0000, v29
  v_fmac_f32 v66, v51, v74
  v_fmac_f32 v67, v51, v75
  v_lshlrev_b32 v72, 16, v30
  v_and_b32 v73, 0xffff0000, v30
  v_fmac_f32 v68, v51, v72
  v_fmac_f32 v69, v51, v73
  v_lshlrev_b32 v74, 16, v31
  v_and_b32 v75, 0xffff0000, v31
  v_fmac_f32 v70, v51, v74
  v_fmac_f32 v71, v51, v75
  s_nop 1
  v_add_f32_dpp v64, v64, v64 quad_perm:[2,3,0,1] row_mask:0xf bank_mask:0xf
  v_add_f32_dpp v65, v65, v65 quad_perm:[2,3,0,1] row_mask:0xf bank_mask:0xf
  v_add_f32_dpp v66, v66, v66 quad_perm:[2,3,0,1] row_mask:0xf bank_mask:0xf
  v_add_f32_dpp v67, v67, v67 quad_perm:[2,3,0,1] row_mask:0xf bank_mask:0xf
  v_add_f32_dpp v68, v68, v68 quad_perm:[2,3,0,1] row_mask:0xf bank_mask:0xf
  v_add_f32_dpp v69, v69, v69 quad_perm:[2,3,0,1] row_mask:0xf bank_mask:0xf
  v_add_f32_dpp v70, v70, v70 quad_perm:[2,3,0,1] row_mask:0xf bank_mask:0xf
  v_add_f32_dpp v71, v71, v71 quad_perm:[2,3,0,1] row_mask:0xf bank_mask:0xf
  v_add_f32_dpp v64, v64, v64 row_ror:4 row_mask:0xf bank_mask:0xf
  v_add_f32_dpp v65, v65, v65 row_ror:4 row_mask:0xf bank_mask:0xf
  v_add_f32_dpp v66, v66, v66 row_ror:4 row_mask:0xf bank_mask:0xf
  v_add_f32_dpp v67, v67, v67 row_ror:4 row_mask:0xf bank_mask:0xf
  v_add_f32_dpp v68, v68, v68 row_ror:4 row_mask:0xf bank_mask:0xf
  v_add_f32_dpp v69, v69, v69 row_ror:4 row_mask:0xf bank_mask:0xf
  v_add_f32_dpp v70, v70, v70 row_ror:4 row_mask:0xf bank_mask:0xf
  v_add_f32_dpp v71, v71, v71 row_ror:4 row_mask:0xf bank_mask:0xf
  v_add_f32_dpp v64, v64, v64 row_ror:8 row_mask:0xf bank_mask:0xf
  v_add_f32_dpp v65, v65, v65 row_ror:8 row_mask:0xf bank_mask:0xf
  v_add_f32_dpp v66, v66, v66 row_ror:8 row_mask:0xf bank_mask:0xf
  v_add_f32_dpp v67, v67, v67 row_ror:8 row_mask:0xf bank_mask:0xf
  v_add_f32_dpp v68, v68, v68 row_ror:8 row_mask:0xf bank_mask:0xf
  v_add_f32_dpp v69, v69, v69 row_ror:8 row_mask:0xf bank_mask:0xf
  v_add_f32_dpp v70, v70, v70 row_ror:8 row_mask:0xf bank_mask:0xf
  v_add_f32_dpp v71, v71, v71 row_ror:8 row_mask:0xf bank_mask:0xf
  s_nop 1
  v_permlane16_swap_b32 v64, v65
  v_permlane16_swap_b32 v66, v67
  v_permlane16_swap_b32 v68, v69
  v_permlane16_swap_b32 v70, v71
  s_nop 1
  v_add_f32 v64, v64, v65
  v_add_f32 v66, v66, v67
  v_add_f32 v68, v68, v69
  v_add_f32 v70, v70, v71
  s_nop 1
  v_permlane32_swap_b32 v64, v66
  v_permlane32_swap_b32 v68, v70
  s_nop 1
  v_add_f32 v64, v64, v66
  v_add_f32 v68, v68, v70
  s_mov_b64 exec, s[96:97]
  ds_write2_b32 v116, v64, v68 offset0:0 offset1:4
  s_mov_b64 exec, -1
  s_waitcnt lgkmcnt(0)
  s_barrier
  s_cmp_lg_u32 s91, 0
  s_cbranch_scc1 L_p_nopub
  ds_read_b64 v[48:49], v117 offset:34048
  ds_read_b64 v[50:51], v117 offset:34112
  ds_read_b64 v[52:53], v117 offset:34176
  ds_read_b64 v[54:55], v117 offset:34240
  s_waitcnt lgkmcnt(0)
  v_add_f32 v48, v48, v50
  v_add_f32 v49, v49, v51
  v_add_f32 v52, v52, v54
  v_add_f32 v53, v53, v55
  v_add_f32 v48, v48, v52
  v_add_f32 v49, v49, v53
  v_cvt_pk_bf16_f32 v48, v48, v49
  v_mov_b32 v49, s90
  s_mov_b64 exec, 255
  buffer_store_dwordx2 v[48:49], v118, s[4:7], 0 offen sc1
  s_mov_b64 exec, -1
L_p_nopub:
  s_barrier
L_a_poll:
  s_cmp_lg_u32 s91, 1
  s_cbranch_scc1 L_a_noq
  s_sleep 12
  buffer_load_dwordx4 v[64:67], v60, s[4:7], 0 offen sc1
  buffer_load_dwordx4 v[68:71], v60, s[4:7], 0 offen offset:1024 sc1
  s_sleep 12
  buffer_load_dwordx4 v[72:75], v60, s[4:7], 0 offen sc1
  buffer_load_dwordx4 v[76:79], v60, s[4:7], 0 offen offset:1024 sc1
  s_sleep 12
  buffer_load_dwordx4 v[80:83], v60, s[4:7], 0 offen sc1
  buffer_load_dwordx4 v[84:87], v60, s[4:7], 0 offen offset:1024 sc1
  s_sleep 12
  buffer_load_dwordx4 v[88:91], v60, s[4:7], 0 offen sc1
  buffer_load_dwordx4 v[92:95], v60, s[4:7], 0 offen offset:1024 sc1
  s_mov_b32 s99, 200000
L_poll1:
  s_waitcnt vmcnt(6)
  v_xor_b32 v56, s90, v65
  v_xor_b32 v57, s90, v67
  v_or_b32 v56, v56, v57
  v_xor_b32 v57, s90, v69
  v_or_b32 v56, v56, v57
  v_xor_b32 v57, s90, v71
  v_or_b32 v56, v56, v57
  v_cmp_ne_u32 vcc, 0, v56
  s_cbranch_vccz L_q_ok0
  buffer_load_dwordx4 v[64:67], v60, s[4:7], 0 offen sc1
  buffer_load_dwordx4 v[68:71], v60, s[4:7], 0 offen offset:1024 sc1
  s_waitcnt vmcnt(6)
  v_xor_b32 v56, s90, v73
  v_xor_b32 v57, s90, v75
  v_or_b32 v56, v56, v57
  v_xor_b32 v57, s90, v77
  v_or_b32 v56, v56, v57
  v_xor_b32 v57, s90, v79
  v_or_b32 v56, v56, v57
  v_cmp_ne_u32 vcc, 0, v56
  s_cbranch_vccz L_q_ok1
  buffer_load_dwordx4 v[72:75], v60, s[4:7], 0 offen sc1
  buffer_load_dwordx4 v[76:79], v60, s[4:7], 0 offen offset:1024 sc1
  s_waitcnt vmcnt(6)
  v_xor_b32 v56, s90, v81
  v_xor_b32 v57, s90, v83
  v_or_b32 v56, v56, v57
  v_xor_b32 v57, s90, v85
  v_or_b32 v56, v56, v57
  v_xor_b32 v57, s90, v87
  v_or_b32 v56, v56, v57
  v_cmp_ne_u32 vcc, 0, v56
  s_cbranch_vccz L_q_ok2
  buffer_load_dwordx4 v[80:83], v60, s[4:7], 0 offen sc1
  buffer_load_dwordx4 v[84:87], v60, s[4:7], 0 offen offset:1024 sc1
  s_waitcnt vmcnt(6)
  v_xor_b32 v56, s90, v89
  v_xor_b32 v57, s90, v91
  v_or_b32 v56, v56, v57
  v_xor_b32 v57, s90, v93
  v_or_b32 v56, v56, v57
  v_xor_b32 v57, s90, v95
  v_or_b32 v56, v56, v57
  v_cmp_ne_u32 vcc, 0, v56
  s_cbranch_vccz L_q_ok3
  buffer_load_dwordx4 v[88:91], v60, s[4:7], 0 offen sc1
  buffer_load_dwordx4 v[92:95], v60, s[4:7], 0 offen offset:1024 sc1
  s_sub_u32 s99, s99, 1
  s_cmp_lg_u32 s99, 0
  s_cbranch_scc1 L_poll1
L_q_ok0:
  v_mov_b32 v65, v66
  v_mov_b32 v69, v70
  ds_write_b64 v61, v[64:65]
  ds_write_b64 v61, v[68:69] offset:640
  s_branch L_q_done
L_q_ok1:
  v_mov_b32 v73, v74
  v_mov_b32 v77, v78
  ds_write_b64 v61, v[72:73]
  ds_write_b64 v61, v[76:77] offset:640
  s_branch L_q_done
L_q_ok2:
  v_mov_b32 v81, v82
  v_mov_b32 v85, v86
  ds_write_b64 v61, v[80:81]
  ds_write_b64 v61, v[84:85] offset:640
  s_branch L_q_done
L_q_ok3:
  v_mov_b32 v89, v90
  v_mov_b32 v93, v94
  ds_write_b64 v61, v[88:89]
  ds_write_b64 v61, v[92:93] offset:640
L_q_done:
  s_waitcnt lgkmcnt(0)
L_a_noq:
  s_barrier
  buffer_load_dwordx4 v[16:19], v5, s[16:19], 0 offen nt
  buffer_load_dwordx4 v[20:23], v5, s[16:19], 0 offen offset:1024 nt
  buffer_load_dwordx4 v[24:27], v5, s[16:19], 0 offen offset:2048 nt
  buffer_load_dwordx4 v[28:31], v5, s[16:19], 0 offen offset:3072 nt
  s_barrier
  s_barrier
  s_waitcnt vmcnt(0)
  v_lshlrev_b32 v64, 16, v16
  v_and_b32 v65, 0xffff0000, v16
  v_lshlrev_b32 v66, 16, v17
  v_and_b32 v67, 0xffff0000, v17
  v_lshlrev_b32 v68, 16, v18
  v_and_b32 v69, 0xffff0000, v18
  v_lshlrev_b32 v70, 16, v19
  v_and_b32 v71, 0xffff0000, v19
  v_lshlrev_b32 v72, 16, v20
  v_and_b32 v73, 0xffff0000, v20
  v_lshlrev_b32 v74, 16, v21
  v_and_b32 v75, 0xffff0000, v21
  v_lshlrev_b32 v76, 16, v22
  v_and_b32 v77, 0xffff0000, v22
  v_lshlrev_b32 v78, 16, v23
  v_and_b32 v79, 0xffff0000, v23
  v_lshlrev_b32 v80, 16, v24
  v_and_b32 v81, 0xffff0000, v24
  v_lshlrev_b32 v82, 16, v25
  v_and_b32 v83, 0xffff0000, v25
  v_lshlrev_b32 v84, 16, v26
  v_and_b32 v85, 0xffff0000, v26
  v_lshlrev_b32 v86, 16, v27
  v_and_b32 v87, 0xffff0000, v27
  v_lshlrev_b32 v88, 16, v28
  v_and_b32 v89, 0xffff0000, v28
  v_lshlrev_b32 v90, 16, v29
  v_and_b32 v91, 0xffff0000, v29
  v_lshlrev_b32 v92, 16, v30
  v_and_b32 v93, 0xffff0000, v30
  v_lshlrev_b32 v94, 16, v31
  v_and_b32 v95, 0xffff0000, v31
  s_mov_b32 s99, 200000
  s_cmp_lg_u32 s91, 0
  s_cbranch_scc1 L_ml_wait
L_poll2a:
  buffer_load_dwordx4 v[96:99], v9, s[4:7], 0 offen sc1
  s_waitcnt vmcnt(0)
  v_xor_b32 v56, s90, v97
  v_xor_b32 v57, s90, v99
  v_or_b32 v56, v56, v57
  v_cmp_ne_u32 vcc, 0, v56
  s_cbranch_vccz L_poll2a_done
  s_sleep 1
  s_sub_u32 s99, s99, 1
  s_cmp_lg_u32 s99, 0
  s_cbranch_scc1 L_poll2a
L_poll2a_done:
  ds_write2_b32 v59, v96, v98 offset0:0 offset1:1
  s_mov_b32 s99, 200000
  s_waitcnt lgkmcnt(0)
L_ml_wait:
  s_barrier
  buffer_load_dwordx4 v[104:107], v15, s[4:7], 0 offen sc1
  buffer_load_dwordx4 v[108:111], v15, s[4:7], 0 offen offset:16 sc1
  ds_read_b64 v[96:97], v59
  ds_read_b32 v100, v12
  s_waitcnt lgkmcnt(0)
  v_max_f32_dpp v52, v96, v96 quad_perm:[1,0,3,2] row_mask:0xf bank_mask:0xf
  s_nop 1
  v_max_f32_dpp v52, v52, v52 quad_perm:[2,3,0,1] row_mask:0xf bank_mask:0xf
  s_nop 1
  v_max_f32_dpp v52, v52, v52 row_half_mirror row_mask:0xf bank_mask:0xf
  s_nop 1
  v_max_f32_dpp v52, v52, v52 row_mirror row_mask:0xf bank_mask:0xf
  s_nop 0
  v_mov_b32 v53, v52
  s_nop 1
  v_permlane16_swap_b32 v52, v53
  s_nop 1
  v_max_f32 v52, v52, v53
  v_sub_f32 v54, v96, v52
  v_sub_f32 v55, v100, v52
  v_exp_f32 v54, v54
  v_exp_f32 v55, v55
  s_nop 0
  v_mul_f32 v54, v54, v97
  s_nop 1
  v_add_f32_dpp v54, v54, v54 quad_perm:[1,0,3,2] row_mask:0xf bank_mask:0xf
  s_nop 1
  v_add_f32_dpp v54, v54, v54 quad_perm:[2,3,0,1] row_mask:0xf bank_mask:0xf
  s_nop 1
  v_add_f32_dpp v54, v54, v54 row_half_mirror row_mask:0xf bank_mask:0xf
  s_nop 1
  v_add_f32_dpp v54, v54, v54 row_mirror row_mask:0xf bank_mask:0xf
  s_nop 0
  v_mov_b32 v53, v54
  s_nop 1
  v_permlane16_swap_b32 v54, v53
  s_nop 1
  v_add_f32 v54, v54, v53
  v_rcp_f32 v58, v54
L_poll2:
  s_waitcnt vmcnt(0)
  v_xor_b32 v56, s90, v105
  v_xor_b32 v57, s90, v107
  v_or_b32 v56, v56, v57
  v_xor_b32 v57, s90, v109
  v_or_b32 v56, v56, v57
  v_xor_b32 v57, s90, v111
  v_or_b32 v56, v56, v57
  v_cmp_ne_u32 vcc, 0, v56
  s_cbranch_vccz L_poll2_done
  buffer_load_dwordx4 v[104:107], v15, s[4:7], 0 offen sc1
  buffer_load_dwordx4 v[108:111], v15, s[4:7], 0 offen offset:16 sc1
  s_sub_u32 s99, s99, 1
  s_cmp_lg_u32 s99, 0
  s_cbranch_scc1 L_poll2
  s_waitcnt vmcnt(0)
L_poll2_done:
  v_mul_f32 v48, v55, v104
  v_mul_f32 v50, v55, v106
  v_mul_f32 v46, v55, v108
  v_mul_f32 v47, v55, v110
  v_add_f32_dpp v48, v48, v48 row_ror:8 row_mask:0xf bank_mask:0xf
  v_add_f32_dpp v50, v50, v50 row_ror:8 row_mask:0xf bank_mask:0xf
  v_add_f32_dpp v46, v46, v46 row_ror:8 row_mask:0xf bank_mask:0xf
  v_add_f32_dpp v47, v47, v47 row_ror:8 row_mask:0xf bank_mask:0xf
  s_nop 0
  v_permlane16_swap_b32 v48, v50
  v_permlane16_swap_b32 v46, v47
  s_nop 1
  v_add_f32 v48, v48, v50
  v_add_f32 v46, v46, v47
  s_nop 1
  v_permlane32_swap_b32 v48, v46
  s_nop 1
  v_add_f32 v48, v48, v46
  s_mov_b64 exec, s[94:95]
  ds_write_b32 v13, v48
  s_mov_b64 exec, -1
  s_waitcnt lgkmcnt(0)
  s_barrier
  ds_read_b128 v[40:43], v4 offset:43520
  ds_read_b128 v[44:47], v4 offset:43648
  ds_read_b128 v[48:51], v4 offset:43776
  ds_read_b128 v[52:55], v4 offset:43904
  s_waitcnt lgkmcnt(0)
  v_add_f32 v40, v40, v44
  v_add_f32 v48, v48, v52
  v_add_f32 v41, v41, v45
  v_add_f32 v49, v49, v53
  v_add_f32 v42, v42, v46
  v_add_f32 v50, v50, v54
  v_add_f32 v43, v43, v47
  v_add_f32 v51, v51, v55
  v_add_f32 v40, v40, v48
  v_add_f32 v41, v41, v49
  v_add_f32 v42, v42, v50
  v_add_f32 v43, v43, v51
  v_mul_f32 v40, v40, v58
  v_mul_f32 v41, v41, v58
  v_mul_f32 v42, v42, v58
  v_mul_f32 v43, v43, v58
  v_cvt_pk_bf16_f32 v44, v40, v41
  v_cvt_pk_bf16_f32 v45, v42, v43
  v_lshlrev_b32 v10, 16, v44
  v_and_b32 v11, 0xffff0000, v44
  v_lshlrev_b32 v6, 16, v45
  v_and_b32 v7, 0xffff0000, v45
  v_mul_f32 v32, v10, v64
  v_mul_f32 v33, v10, v65
  v_mul_f32 v34, v10, v66
  v_mul_f32 v35, v10, v67
  v_mul_f32 v36, v10, v68
  v_mul_f32 v37, v10, v69
  v_mul_f32 v38, v10, v70
  v_mul_f32 v39, v10, v71
  v_fmac_f32 v32, v11, v72
  v_fmac_f32 v33, v11, v73
  v_fmac_f32 v34, v11, v74
  v_fmac_f32 v35, v11, v75
  v_fmac_f32 v36, v11, v76
  v_fmac_f32 v37, v11, v77
  v_fmac_f32 v38, v11, v78
  v_fmac_f32 v39, v11, v79
  v_fmac_f32 v32, v6, v80
  v_fmac_f32 v33, v6, v81
  v_fmac_f32 v34, v6, v82
  v_fmac_f32 v35, v6, v83
  v_fmac_f32 v36, v6, v84
  v_fmac_f32 v37, v6, v85
  v_fmac_f32 v38, v6, v86
  v_fmac_f32 v39, v6, v87
  v_fmac_f32 v32, v7, v88
  v_fmac_f32 v33, v7, v89
  v_fmac_f32 v34, v7, v90
  v_fmac_f32 v35, v7, v91
  v_fmac_f32 v36, v7, v92
  v_fmac_f32 v37, v7, v93
  v_fmac_f32 v38, v7, v94
  v_fmac_f32 v39, v7, v95
  s_nop 0
  v_add_f32_dpp v32, v32, v32 row_ror:8 row_mask:0xf bank_mask:0xf
  v_add_f32_dpp v33, v33, v33 row_ror:8 row_mask:0xf bank_mask:0xf
  v_add_f32_dpp v34, v34, v34 row_ror:8 row_mask:0xf bank_mask:0xf
  v_add_f32_dpp v35, v35, v35 row_ror:8 row_mask:0xf bank_mask:0xf
  v_add_f32_dpp v36, v36, v36 row_ror:8 row_mask:0xf bank_mask:0xf
  v_add_f32_dpp v37, v37, v37 row_ror:8 row_mask:0xf bank_mask:0xf
  v_add_f32_dpp v38, v38, v38 row_ror:8 row_mask:0xf bank_mask:0xf
  v_add_f32_dpp v39, v39, v39 row_ror:8 row_mask:0xf bank_mask:0xf
  s_nop 0
  v_permlane16_swap_b32 v32, v34
  v_permlane16_swap_b32 v33, v35
  v_permlane16_swap_b32 v36, v38
  v_permlane16_swap_b32 v37, v39
  s_nop 0
  v_add_f32 v32, v32, v34
  v_add_f32 v33, v33, v35
  v_add_f32 v36, v36, v38
  v_add_f32 v37, v37, v39
  s_nop 1
  v_permlane32_swap_b32 v32, v36
  v_permlane32_swap_b32 v33, v37
  s_nop 1
  v_add_f32 v32, v32, v36
  v_add_f32 v34, v33, v37
  v_mov_b32 v33, s90
  v_mov_b32 v35, s90
  s_mov_b64 exec, s[94:95]
  buffer_store_dwordx4 v[32:35], v62, s[4:7], 0 offen sc1
  s_mov_b64 exec, -1
  s_cmp_lg_u32 s91, 0
  s_cbranch_scc1 L_end
  s_lshl_b32 s32, s92, 7
  s_lshl_b32 s33, s93, 2
  s_add_u32 s32, s32, s33
  v_mov_b32 v9, s32
  s_mov_b32 s99, 200000
  s_mov_b64 s[32:33], -1
  s_mov_b64 s[34:35], -1
L_poll3:
  s_mov_b64 exec, s[32:33]
  buffer_load_dwordx4 v[64:67], v1, s[4:7], 0 offen sc1
  s_mov_b64 exec, s[34:35]
  buffer_load_dwordx4 v[68:71], v1, s[4:7], 0 offen offset:1024 sc1
  s_mov_b64 exec, -1
  s_waitcnt vmcnt(0)
  v_xor_b32 v56, s90, v65
  v_xor_b32 v57, s90, v67
  v_or_b32 v56, v56, v57
  v_cmp_ne_u32 s[32:33], 0, v56
  v_xor_b32 v56, s90, v69
  v_xor_b32 v57, s90, v71
  v_or_b32 v56, v56, v57
  v_cmp_ne_u32 s[34:35], 0, v56
  s_nop 3
  s_or_b64 s[36:37], s[32:33], s[34:35]
  s_cbranch_scc0 L_poll3_done
  s_sub_u32 s99, s99, 1
  s_cmp_lg_u32 s99, 0
  s_cbranch_scc1 L_poll3
L_poll3_done:
  v_add_f32 v40, v64, v68
  v_add_f32 v42, v66, v70
  s_nop 1
  v_permlane16_swap_b32 v40, v42
  s_nop 1
  v_add_f32 v40, v40, v42
  v_mov_b32 v42, v40
  s_nop 1
  v_permlane32_swap_b32 v40, v42
  s_nop 1
  v_add_f32 v40, v40, v42
  s_nop 1
  v_add_f32_dpp v40, v40, v40 quad_perm:[1,0,3,2] row_mask:0xf bank_mask:0xf
  s_nop 1
  v_add_f32_dpp v40, v40, v40 quad_perm:[2,3,0,1] row_mask:0xf bank_mask:0xf
  s_nop 1
  v_add_f32_dpp v40, v40, v40 row_half_mirror row_mask:0xf bank_mask:0xf
  s_nop 1
  v_add_f32_dpp v40, v40, v40 row_mirror row_mask:0xf bank_mask:0xf
  s_nop 1
  v_readlane_b32 s32, v40, 16
  v_mov_b32 v42, s32
  v_cvt_pk_bf16_f32 v40, v40, v42
  s_mov_b64 exec, 1
  buffer_store_dword v40, v9, s[20:23], 0 offen
  s_cmp_lg_u32 s2, 0
  s_cbranch_scc1 L_a_nononce
  v_mov_b32 v40, s90
  v_mov_b32 v9, 0
  buffer_store_dword v40, v9, s[4:7], 0 offen sc1
L_a_nononce:
  s_mov_b64 exec, -1
  s_branch L_end
L_bwave:
  s_lshl_b32 s35, s92, 15
  s_add_u32 s35, s35, 28672
  s_lshl_b32 s33, s93, 7
  s_add_u32 s35, s35, s33
  s_lshl_b32 s33, s91, 5
  s_add_u32 s35, s35, s33
  s_lshl_b32 s35, s35, 8
  v_and_b32 v122, 15, v0
  v_lshrrev_b32 v123, 4, v0
  v_lshlrev_b32 v122, 8, v122
  v_lshl_add_u32 v122, v123, 4, v122
  v_add_u32 v122, s35, v122
  s_movk_i32 s33, 0x1000
  s_mov_b32 s32, s35
  v_and_b32 v2, 15, v0
  v_lshrrev_b32 v3, 4, v0
  v_lshlrev_b32 v5, 1, v3
  v_xor_b32 v5, v5, v2
  v_lshlrev_b32 v6, 8, v3
  v_lshl_add_u32 v7, v5, 4, v6
  v_add_u32 v7, s32, v7
  v_xor_b32 v5, 8, v5
  v_lshl_add_u32 v8, v5, 4, v6
  v_add_u32 v8, s32, v8
  v_add_u32 v8, 0x400, v8
  s_lshl_b32 s34, s91, 13
  buffer_load_dwordx4 v[16:19], v122, s[8:11], 0 offen offset:0 nt
  buffer_load_dwordx4 v[20:23], v122, s[8:11], 0 offen offset:64 nt
  buffer_load_dwordx4 v[24:27], v122, s[8:11], 0 offen offset:128 nt
  buffer_load_dwordx4 v[28:31], v122, s[8:11], 0 offen offset:192 nt
  buffer_load_dwordx4 v[32:35], v122, s[8:11], s33 offen offset:0 nt
  s_barrier
  s_barrier
L_b_go:
  buffer_load_dwordx4 v[36:39], v122, s[8:11], s33 offen offset:64 nt
  buffer_load_dwordx4 v[40:43], v122, s[8:11], s33 offen offset:128 nt
  buffer_load_dwordx4 v[44:47], v122, s[8:11], s33 offen offset:192 nt
  s_add_u32 m0, s34, 0
  s_movk_i32 s35, 0
  buffer_load_dwordx4 v7, s[12:15], s35 offen nt lds
  s_add_u32 m0, s34, 1024
  s_movk_i32 s35, 0
  buffer_load_dwordx4 v8, s[12:15], s35 offen nt lds
  s_add_u32 m0, s34, 2048
  s_movk_i32 s35, 2048
  buffer_load_dwordx4 v7, s[12:15], s35 offen nt lds
  s_add_u32 m0, s34, 3072
  s_movk_i32 s35, 2048
  buffer_load_dwordx4 v8, s[12:15], s35 offen nt lds
  s_add_u32 m0, s34, 4096
  s_movk_i32 s35, 4096
  buffer_load_dwordx4 v7, s[12:15], s35 offen nt lds
  s_add_u32 m0, s34, 5120
  s_movk_i32 s35, 4096
  buffer_load_dwordx4 v8, s[12:15], s35 offen nt lds
  s_add_u32 m0, s34, 6144
  s_movk_i32 s35, 6144
  buffer_load_dwordx4 v7, s[12:15], s35 offen nt lds
  s_add_u32 m0, s34, 7168
  s_movk_i32 s35, 6144
  buffer_load_dwordx4 v8, s[12:15], s35 offen nt lds
  v_and_b32 v9, 3, v0
  v_mul_u32_u24 v9, 320, v9
  v_lshl_add_u32 v9, v3, 4, v9
  v_add_u32 v9, 32768, v9
  v_lshrrev_b32 v10, 2, v2
  v_lshl_add_u32 v10, v3, 2, v10
  v_and_b32 v11, 7, v10
  v_lshlrev_b32 v11, 5, v11
  v_lshl_add_u32 v11, v10, 8, v11
  v_and_b32 v12, 3, v0
  v_lshl_add_u32 v11, v12, 3, v11
  v_add_u32 v11, s34, v11
  v_and_b32 v13, 3, v0
  v_lshlrev_b32 v14, 3, v13
  v_mul_u32_u24 v13, 576, v13
  v_lshl_add_u32 v13, v3, 4, v13
  s_mul_i32 s33, s91, 2304
  s_add_u32 s33, s33, 34048
  v_add_u32 v13, s33, v13
  s_lshl_b32 s33, s91, 5
  s_add_u32 s33, s33, 43264
  v_add_u32 v14, s33, v14
  s_mul_i32 s33, s91, 576
  s_add_u32 s33, s33, 34048
  v_lshlrev_b32 v15, 3, v0
  v_add_u32 v15, s33, v15
  s_lshl_b32 s33, s92, 2
  s_add_u32 s33, s33, s91
  s_lshl_b32 s33, s33, 5
  s_add_u32 s33, s33, s93
  s_lshl_b32 s35, s33, 10
  s_add_u32 s35, s35, 262144
  v_lshlrev_b32 v116, 4, v0
  v_add_u32 v116, s35, v116
  s_lshl_b32 s35, s33, 4
  s_add_u32 s35, s35, 196608
  v_mov_b32 v117, s35
  s_lshl_b32 s33, s91, 3
  s_add_u32 s33, s33, 43264
  v_mov_b32 v118, s33
  v_cmp_gt_u32 s[94:95], 4, v2
  s_waitcnt lgkmcnt(0)
  s_add_u32 s90, s90, 1
  s_mov_b32 s32, 0x3db504f3
  s_mov_b32 s33, 0x3db504f3
  s_mov_b32 s34, 0x3fb8aa3b
  s_waitcnt lgkmcnt(0)
  s_barrier
  ds_read_b128 v[48:51], v9 offset:0
  ds_read_b128 v[52:55], v9 offset:64
  ds_read_b128 v[56:59], v9 offset:128
  ds_read_b128 v[60:63], v9 offset:192
  s_waitcnt vmcnt(8)
  s_waitcnt lgkmcnt(3)
  v_mfma_f32_16x16x32_bf16 v[64:67], v[16:19], v[48:51], 0
  v_mfma_f32_16x16x32_bf16 v[68:71], v[32:35], v[48:51], 0
  s_waitcnt lgkmcnt(2)
  v_mfma_f32_16x16x32_bf16 v[64:67], v[20:23], v[52:55], v[64:67]
  v_mfma_f32_16x16x32_bf16 v[68:71], v[36:39], v[52:55], v[68:71]
  s_waitcnt lgkmcnt(1)
  v_mfma_f32_16x16x32_bf16 v[64:67], v[24:27], v[56:59], v[64:67]
  v_mfma_f32_16x16x32_bf16 v[68:71], v[40:43], v[56:59], v[68:71]
  s_waitcnt lgkmcnt(0)
  v_mfma_f32_16x16x32_bf16 v[64:67], v[28:31], v[60:63], v[64:67]
  v_mfma_f32_16x16x32_bf16 v[68:71], v[44:47], v[60:63], v[68:71]
  s_nop 7
  s_nop 3
  v_cvt_pk_bf16_f32 v72, v64, v65
  v_cvt_pk_bf16_f32 v73, v66, v67
  v_cvt_pk_bf16_f32 v74, v68, v69
  v_cvt_pk_bf16_f32 v75, v70, v71
  v_lshlrev_b32 v64, 16, v72
  v_and_b32 v65, 0xffff0000, v72
  v_lshlrev_b32 v66, 16, v73
  v_and_b32 v67, 0xffff0000, v73
  v_lshlrev_b32 v68, 16, v74
  v_and_b32 v69, 0xffff0000, v74
  v_lshlrev_b32 v70, 16, v75
  v_and_b32 v71, 0xffff0000, v75
  v_pk_mul_f32 v[64:65], v[64:65], s[32:33]
  v_pk_mul_f32 v[66:67], v[66:67], s[32:33]
  v_pk_mul_f32 v[68:69], v[68:69], s[32:33]
  v_pk_mul_f32 v[70:71], v[70:71], s[32:33]
  v_cvt_pk_bf16_f32 v72, v64, v65
  v_cvt_pk_bf16_f32 v73, v66, v67
  v_cvt_pk_bf16_f32 v74, v68, v69
  v_cvt_pk_bf16_f32 v75, v70, v71
  v_lshlrev_b32 v64, 16, v72
  v_and_b32 v65, 0xffff0000, v72
  v_lshlrev_b32 v66, 16, v73
  v_and_b32 v67, 0xffff0000, v73
  v_lshlrev_b32 v68, 16, v74
  v_and_b32 v69, 0xffff0000, v74
  v_lshlrev_b32 v70, 16, v75
  v_and_b32 v71, 0xffff0000, v75
  v_max3_f32 v76, v64, v65, v66
  v_max3_f32 v77, v67, v68, v69
  v_max3_f32 v76, v76, v70, v71
  v_max_f32 v76, v76, v77
  v_mov_b32 v77, v76
  s_nop 1
  v_permlane16_swap_b32 v76, v77
  s_nop 1
  v_max_f32 v76, v76, v77
  v_mov_b32 v77, v76
  s_nop 1
  v_permlane32_swap_b32 v76, v77
  s_nop 1
  v_max_f32 v76, v76, v77
  v_mul_f32 v76, s34, v76
  v_fma_f32 v64, v64, s34, -v76
  v_fma_f32 v65, v65, s34, -v76
  v_fma_f32 v66, v66, s34, -v76
  v_fma_f32 v67, v67, s34, -v76
  v_fma_f32 v68, v68, s34, -v76
  v_fma_f32 v69, v69, s34, -v76
  v_fma_f32 v70, v70, s34, -v76
  v_fma_f32 v71, v71, s34, -v76
  v_exp_f32 v64, v64
  v_exp_f32 v65, v65
  v_exp_f32 v66, v66
  v_exp_f32 v67, v67
  v_exp_f32 v68, v68
  v_exp_f32 v69, v69
  v_exp_f32 v70, v70
  v_exp_f32 v71, v71
  s_nop 0
  v_cvt_pk_bf16_f32 v72, v64, v65
  v_cvt_pk_bf16_f32 v73, v66, v67
  v_cvt_pk_bf16_f32 v74, v68, v69
  v_cvt_pk_bf16_f32 v75, v70, v71
  v_add_f32 v77, v64, v65
  v_add_f32 v78, v66, v67
  v_add_f32 v79, v68, v69
  v_add_f32 v80, v70, v71
  v_add_f32 v77, v77, v78
  v_add_f32 v79, v79, v80
  v_add_f32 v77, v77, v79
  v_mov_b32 v78, v77
  s_nop 1
  v_permlane16_swap_b32 v77, v78
  s_nop 1
  v_add_f32 v77, v77, v78
  v_mov_b32 v78, v77
  s_nop 1
  v_permlane32_swap_b32 v77, v78
  s_nop 1
  v_add_f32 v77, v77, v78
  s_mov_b64 exec, s[94:95]
  ds_write_b64 v14, v[76:77]
  s_mov_b64 exec, -1
  v_xor_b32 v48, 0, v11
  v_xor_b32 v49, 32, v11
  v_xor_b32 v50, 64, v11
  v_xor_b32 v51, 96, v11
  v_xor_b32 v52, 128, v11
  v_xor_b32 v53, 160, v11
  v_xor_b32 v54, 192, v11
  v_xor_b32 v55, 224, v11
  s_waitcnt lgkmcnt(0)
  s_barrier
  ds_read_b64 v[56:57], v118 offset:0
  ds_read_b64 v[58:59], v118 offset:32
  ds_read_b64 v[60:61], v118 offset:64
  ds_read_b64 v[62:63], v118 offset:96
  v_mov_b32 v81, s90
  v_mov_b32 v83, s90
  s_waitcnt vmcnt(0) lgkmcnt(0)
  ds_read_b64_tr_b16 v[84:85], v48
  ds_read_b64_tr_b16 v[86:87], v48 offset:4096
  ds_read_b64_tr_b16 v[88:89], v49
  ds_read_b64_tr_b16 v[90:91], v49 offset:4096
  ds_read_b64_tr_b16 v[92:93], v50
  ds_read_b64_tr_b16 v[94:95], v50 offset:4096
  ds_read_b64_tr_b16 v[96:97], v51
  ds_read_b64_tr_b16 v[98:99], v51 offset:4096
  ds_read_b64_tr_b16 v[100:101], v52
  ds_read_b64_tr_b16 v[102:103], v52 offset:4096
  ds_read_b64_tr_b16 v[104:105], v53
  ds_read_b64_tr_b16 v[106:107], v53 offset:4096
  ds_read_b64_tr_b16 v[108:109], v54
  ds_read_b64_tr_b16 v[110:111], v54 offset:4096
  ds_read_b64_tr_b16 v[112:113], v55
  ds_read_b64_tr_b16 v[114:115], v55 offset:4096
  v_max3_f32 v80, v56, v58, v60
  v_max_f32 v80, v80, v62
  v_sub_f32 v120, v56, v80
  v_sub_f32 v121, v58, v80
  v_sub_f32 v122, v60, v80
  v_sub_f32 v123, v62, v80
  v_exp_f32 v120, v120
  v_exp_f32 v121, v121
  v_exp_f32 v122, v122
  v_exp_f32 v123, v123
  s_nop 0
  v_mul_f32 v82, v120, v57
  v_fmac_f32 v82, v121, v59
  v_fmac_f32 v82, v122, v61
  v_fmac_f32 v82, v123, v63
  s_mov_b64 exec, 1
  buffer_store_dwordx4 v[80:83], v117, s[4:7], 0 offen sc1
  s_mov_b64 exec, -1
  s_waitcnt lgkmcnt(14)
  v_mfma_f32_16x16x32_bf16 v[16:19], v[84:87], v[72:75], 0
  s_waitcnt lgkmcnt(12)
  v_mfma_f32_16x16x32_bf16 v[20:23], v[88:91], v[72:75], 0
  s_waitcnt lgkmcnt(10)
  v_mfma_f32_16x16x32_bf16 v[24:27], v[92:95], v[72:75], 0
  s_waitcnt lgkmcnt(8)
  v_mfma_f32_16x16x32_bf16 v[28:31], v[96:99], v[72:75], 0
  s_waitcnt lgkmcnt(6)
  v_mfma_f32_16x16x32_bf16 v[32:35], v[100:103], v[72:75], 0
  s_waitcnt lgkmcnt(4)
  v_mfma_f32_16x16x32_bf16 v[36:39], v[104:107], v[72:75], 0
  s_waitcnt lgkmcnt(2)
  v_mfma_f32_16x16x32_bf16 v[40:43], v[108:111], v[72:75], 0
  s_waitcnt lgkmcnt(0)
  v_mfma_f32_16x16x32_bf16 v[44:47], v[112:115], v[72:75], 0
  s_mov_b64 exec, s[94:95]
  s_nop 7
  s_nop 3
  ds_write_b128 v13, v[16:19] offset:0
  ds_write_b128 v13, v[20:23] offset:64
  ds_write_b128 v13, v[24:27] offset:128
  ds_write_b128 v13, v[28:31] offset:192
  ds_write_b128 v13, v[32:35] offset:256
  ds_write_b128 v13, v[36:39] offset:320
  ds_write_b128 v13, v[40:43] offset:384
  ds_write_b128 v13, v[44:47] offset:448
  s_mov_b64 exec, -1
  s_waitcnt lgkmcnt(0)
  s_barrier
  ds_read_b64 v[56:57], v15 offset:0
  ds_read_b64 v[58:59], v15 offset:2304
  ds_read_b64 v[60:61], v15 offset:4608
  ds_read_b64 v[62:63], v15 offset:6912
  v_mov_b32 v41, s90
  v_mov_b32 v43, s90
  s_waitcnt lgkmcnt(0)
  v_mul_f32 v40, v120, v56
  v_mul_f32 v42, v120, v57
  v_fmac_f32 v40, v121, v58
  v_fmac_f32 v42, v121, v59
  v_fmac_f32 v40, v122, v60
  v_fmac_f32 v42, v122, v61
  v_fmac_f32 v40, v123, v62
  v_fmac_f32 v42, v123, v63
  buffer_store_dwordx4 v[40:43], v116, s[4:7], 0 offen sc1
L_end:
L_end2:
  s_endpgm
.section .rodata,"a"
.p2align 6
.amdhsa_kernel standalone__sliding_block_cached__decode_kernel
  .amdhsa_next_free_vgpr 128
  .amdhsa_next_free_sgpr 102
  .amdhsa_accum_offset 128
  .amdhsa_group_segment_fixed_size 0
  .amdhsa_kernarg_size 64
  .amdhsa_user_sgpr_count 2
  .amdhsa_user_sgpr_kernarg_segment_ptr 1
  .amdhsa_system_sgpr_workgroup_id_x 1
.end_amdhsa_kernel
```
